```python
import torch

def _softmax(x, axis=-1):
    return torch.softmax(x, dim=axis)
def _gelu(x):
    return torch.nn.functional.gelu(x, approximate="tanh")
def _silu(x):
    return torch.nn.functional.silu(x)
def _sigmoid(x):
    return torch.sigmoid(x)
def _layernorm(x, axis=-1, eps=1e-5):
    m = x.mean(dim=axis, keepdim=True)
    v = x.var(dim=axis, keepdim=True, unbiased=False)
    return (x - m) / torch.sqrt(v + eps)
def _scatter_add(tgt, idx, src, axis=0):
    return tgt.clone().index_add_(axis, idx, src)
def _segment_sum(src, seg, n):
    out = torch.zeros((n,) + src.shape[1:], dtype=src.dtype)
    return out.index_add_(0, seg, src)
def _pad(x, pw):
    flat = tuple(v for pair in reversed(pw) for v in pair)
    return torch.nn.functional.pad(x, flat)

kernel_name = 'concat_heads__gqa_block_cached__gqa_block_cached__decode'

def setup_inputs():

    _w = (lambda a: (lambda t: t.to(torch.bfloat16) if t.is_floating_point() else t)(torch.as_tensor(a)))
    def _A_setup():
        B, Sq, D = 8, 1, 512
        Hq, Hkv, Sk, Dh = 32, 8, 8192, 128
        assert Hq % Hkv == 0, (Hq, Hkv)
        return {
            "x": _w((lambda *s: torch.randn(*s, dtype=torch.bfloat16) * 0.8)(B, Sq, D)),
            "k_cache": _w((lambda *s: torch.randn(*s, dtype=torch.bfloat16) * 0.8)(B, Hkv, Sk, Dh)),
            "v_cache": _w((lambda *s: torch.randn(*s, dtype=torch.bfloat16) * 0.05)(B, Hkv, Sk, Dh)),
            "wq": _w((lambda *s: torch.randn(*s, dtype=torch.bfloat16) * 0.8)(D, Hq * Dh) * (D ** -0.5)),
            "wo": _w((lambda *s: torch.randn(*s, dtype=torch.bfloat16) * 0.05)(Hq * Dh, D) * ((Hq * Dh) ** -0.5)),
        }
    _A_in = _A_setup()

    def _B_setup():
        B, Sq, D = 8, 1, 512
        Hq, Hkv, Sk, Dh = 32, 8, 8192, 128
        assert Hq % Hkv == 0, (Hq, Hkv)
        return {
            "x": _w((lambda *s: torch.randn(*s, dtype=torch.bfloat16) * 0.8)(B, Sq, D)),
            "k_cache": _w((lambda *s: torch.randn(*s, dtype=torch.bfloat16) * 0.8)(B, Hkv, Sk, Dh)),
            "v_cache": _w((lambda *s: torch.randn(*s, dtype=torch.bfloat16) * 0.05)(B, Hkv, Sk, Dh)),
            "wq": _w((lambda *s: torch.randn(*s, dtype=torch.bfloat16) * 0.8)(D, Hq * Dh) * (D ** -0.5)),
            "wo": _w((lambda *s: torch.randn(*s, dtype=torch.bfloat16) * 0.05)(Hq * Dh, D) * ((Hq * Dh) ** -0.5)),
        }
    _B_in = _B_setup()

    return {
        "A_x": _A_in["x"],
        "A_k_cache": _A_in["k_cache"],
        "A_v_cache": _A_in["v_cache"],
        "A_wq": _A_in["wq"],
        "A_wo": _A_in["wo"],
        "B_x": _B_in["x"],
        "B_k_cache": _B_in["k_cache"],
        "B_v_cache": _B_in["v_cache"],
        "B_wq": _B_in["wq"],
        "B_wo": _B_in["wo"],
    }

def reference(A_x, A_k_cache, A_v_cache, A_wq, A_wo, B_x, B_k_cache, B_v_cache, B_wq, B_wo):
    def _A_ref(x, k_cache, v_cache, wq, wo):
        B, Sq, D = x.shape
        Hq, Dh = 32, 128
        Hkv = k_cache.shape[1]
        rep = Hq // Hkv
        q = (lambda x, *d: x.permute(*d))((x @ wq).reshape(B, Sq, Hq, Dh), 0, 2, 1, 3)
        k = (lambda x, n, axis: torch.repeat_interleave(x, n, dim=axis))(k_cache, rep, axis=1)
        v = (lambda x, n, axis: torch.repeat_interleave(x, n, dim=axis))(v_cache, rep, axis=1)
        scores = torch.einsum("bhqd,bhkd->bhqk", q, k) * (Dh ** -0.5)
        p = _softmax(scores, axis=-1)
        o = torch.einsum("bhqk,bhkd->bhqd", p, v)
        return (lambda x, *d: x.permute(*d))(o, 0, 2, 1, 3).reshape(B, Sq, Hq * Dh) @ wo

    def _B_ref(x, k_cache, v_cache, wq, wo):
        B, Sq, D = x.shape
        Hq, Dh = 32, 128
        Hkv = k_cache.shape[1]
        rep = Hq // Hkv
        q = (lambda x, *d: x.permute(*d))((x @ wq).reshape(B, Sq, Hq, Dh), 0, 2, 1, 3)
        k = (lambda x, n, axis: torch.repeat_interleave(x, n, dim=axis))(k_cache, rep, axis=1)
        v = (lambda x, n, axis: torch.repeat_interleave(x, n, dim=axis))(v_cache, rep, axis=1)
        scores = torch.einsum("bhqd,bhkd->bhqk", q, k) * (Dh ** -0.5)
        p = _softmax(scores, axis=-1)
        o = torch.einsum("bhqk,bhkd->bhqd", p, v)
        return (lambda x, *d: x.permute(*d))(o, 0, 2, 1, 3).reshape(B, Sq, Hq * Dh) @ wo

    a = _A_ref(A_x, A_k_cache, A_v_cache, A_wq, A_wo)
    b = _B_ref(B_x, B_k_cache, B_v_cache, B_wq, B_wo)
    return torch.concatenate([a, b], axis=-1)
```

```asm
; @launch grid=(256,1,1) block=(512,1,1) lds=17680
.amdgcn_target "amdgcn-amd-amdhsa--gfx950"
.text
.globl concat_heads__gqa_block_cached__gqa_block_cached__decode_kernel
.p2align 8
.type concat_heads__gqa_block_cached__gqa_block_cached__decode_kernel,@function
concat_heads__gqa_block_cached__gqa_block_cached__decode_kernel:
    s_cmp_ge_u32 s2, 256
    s_cbranch_scc1 L_end
    s_lshr_b32 s3, s2, 7
    s_lshr_b32 s14, s2, 1
    s_and_b32 s14, s14, 63
    s_and_b32 s15, s2, 1
    s_mul_i32 s4, s3, 40
    s_add_u32 s6, s0, s4
    s_addc_u32 s7, s1, 0
    s_load_dwordx8 s[68:75], s[6:7], 0
    s_load_dwordx2 s[76:77], s[6:7], 32
    s_load_dwordx4 s[52:55], s[0:1], 80
    s_load_dwordx2 s[12:13], s[0:1], 96
    v_and_b32 v11, 63, v0
    v_lshrrev_b32 v5, 6, v0
    s_nop 0
    v_readfirstlane_b32 s16, v5
    v_and_b32 v232, 15, v11
    v_lshrrev_b32 v233, 4, v11
    v_mov_b32 v234, 0
    v_mov_b32 v237, 1
    v_and_b32 v8, 3, v232
    v_lshrrev_b32 v9, 2, v232
    v_lshl_add_u32 v8, v8, 2, v9
    v_lshlrev_b32 v8, 8, v8
    v_lshl_add_u32 v1, v233, 4, v8
    v_add_u32 v2, 0x1000, v1
    v_lshlrev_b32 v3, 4, v11
    v_add_u32 v4, 0x1000, v3
    s_mov_b32 s40, 0x05040100
    s_mov_b32 s41, 0x07060302
    s_mov_b32 s42, 0x3e0293ee
    s_and_b32 s78, s14, 7
    s_lshr_b32 s79, s14, 3
    s_lshl_b32 s80, s79, 1
    s_add_u32 s80, s80, s15
    s_lshl_b32 s81, s3, 3
    s_add_u32 s81, s81, s78
    s_and_b32 s82, s81, 3
    s_lshl_b32 s82, s82, 6
    s_lshr_b32 s83, s81, 2
    s_lshl_b32 s83, s83, 2
    s_add_u32 s82, s82, s83
    s_lshl_b32 s17, s14, 21
    s_mul_i32 s18, s15, 1048576
    s_add_u32 s17, s17, s18
    s_sub_u32 s44, s16, 4
    s_mov_b32 s45, s16
    s_waitcnt lgkmcnt(0)
    s_add_u32 s8, s70, s17
    s_addc_u32 s9, s71, 0
    s_add_u32 s10, s72, s17
    s_addc_u32 s11, s73, 0
    s_mov_b32 s20, s8
    s_and_b32 s21, s9, 0xffff
    s_mov_b32 s22, 1048576
    s_mov_b32 s23, 0x00020000
    s_mov_b32 s24, s10
    s_and_b32 s25, s11, 0xffff
    s_mov_b32 s26, 1048576
    s_mov_b32 s27, 0x00020000
    s_mov_b32 s28, s12
    s_and_b32 s29, s13, 0xffff
    s_mov_b32 s30, 2228224
    s_mov_b32 s31, 0x00020000
    s_mov_b32 s60, s54
    s_and_b32 s61, s55, 0xffff
    s_mov_b32 s62, 256
    s_mov_b32 s63, 0x00020000
    s_cmp_lt_u32 s16, 4
    s_cbranch_scc1 L_qrole
    s_barrier
    s_lshl_b32 s47, s44, 13
    buffer_load_dwordx4 v[72:75], v1, s[20:23], s47 offen offset:0 nt
    buffer_load_dwordx4 v[76:79], v1, s[20:23], s47 offen offset:64 nt
    buffer_load_dwordx4 v[80:83], v1, s[20:23], s47 offen offset:128 nt
    buffer_load_dwordx4 v[84:87], v1, s[20:23], s47 offen offset:192 nt
    buffer_load_dwordx4 v[88:91], v2, s[20:23], s47 offen offset:0 nt
    buffer_load_dwordx4 v[92:95], v2, s[20:23], s47 offen offset:64 nt
    buffer_load_dwordx4 v[96:99], v2, s[20:23], s47 offen offset:128 nt
    buffer_load_dwordx4 v[100:103], v2, s[20:23], s47 offen offset:192 nt
    s_waitcnt vmcnt(0)
    buffer_load_dwordx4 v[136:139], v3, s[24:27], s47 offen offset:0 nt
    buffer_load_dwordx4 v[140:143], v3, s[24:27], s47 offen offset:1024 nt
    buffer_load_dwordx4 v[144:147], v3, s[24:27], s47 offen offset:2048 nt
    buffer_load_dwordx4 v[148:151], v3, s[24:27], s47 offen offset:3072 nt
    buffer_load_dwordx4 v[152:155], v4, s[24:27], s47 offen offset:0 nt
    buffer_load_dwordx4 v[156:159], v4, s[24:27], s47 offen offset:1024 nt
    buffer_load_dwordx4 v[160:163], v4, s[24:27], s47 offen offset:2048 nt
    buffer_load_dwordx4 v[164:167], v4, s[24:27], s47 offen offset:3072 nt
    s_waitcnt vmcnt(0)
    s_lshl_b32 s47, s45, 13
    buffer_load_dwordx4 v[104:107], v1, s[20:23], s47 offen offset:0 nt
    buffer_load_dwordx4 v[108:111], v1, s[20:23], s47 offen offset:64 nt
    buffer_load_dwordx4 v[112:115], v1, s[20:23], s47 offen offset:128 nt
    buffer_load_dwordx4 v[116:119], v1, s[20:23], s47 offen offset:192 nt
    buffer_load_dwordx4 v[120:123], v2, s[20:23], s47 offen offset:0 nt
    buffer_load_dwordx4 v[124:127], v2, s[20:23], s47 offen offset:64 nt
    buffer_load_dwordx4 v[128:131], v2, s[20:23], s47 offen offset:128 nt
    buffer_load_dwordx4 v[132:135], v2, s[20:23], s47 offen offset:192 nt
    s_waitcnt vmcnt(0)
    buffer_load_dwordx4 v[168:171], v3, s[24:27], s47 offen offset:0 nt
    buffer_load_dwordx4 v[172:175], v3, s[24:27], s47 offen offset:1024 nt
    buffer_load_dwordx4 v[176:179], v3, s[24:27], s47 offen offset:2048 nt
    buffer_load_dwordx4 v[180:183], v3, s[24:27], s47 offen offset:3072 nt
    buffer_load_dwordx4 v[184:187], v4, s[24:27], s47 offen offset:0 nt
    buffer_load_dwordx4 v[188:191], v4, s[24:27], s47 offen offset:1024 nt
    buffer_load_dwordx4 v[192:195], v4, s[24:27], s47 offen offset:2048 nt
    buffer_load_dwordx4 v[196:199], v4, s[24:27], s47 offen offset:3072 nt
    s_branch L_qjoin
L_qrole:
    s_lshl_b32 s46, s2, 7
    s_add_u32 s46, s46, 2195456
    s_cmp_eq_u32 s16, 0
    s_cbranch_scc1 L_qwave
    s_barrier
    s_cmp_lg_u32 s16, 1
    s_cbranch_scc1 L_qjoin
    s_cmp_ge_u32 s2, 32
    s_cbranch_scc1 L_qjoin
    v_mov_b32 v28, 0
    v_mov_b32 v29, 0
    v_mov_b32 v30, 0
    v_mov_b32 v31, 0
    v_lshlrev_b32 v8, 4, v11
    s_lshl_b32 s18, s2, 10
    s_add_u32 s18, s18, 2162688
    buffer_store_dwordx4 v[28:31], v8, s[28:31], s18 offen sc1
    s_waitcnt vmcnt(0)
    s_mov_b64 exec, 1
    buffer_atomic_add v237, v234, s[60:63], 0 offen offset:48
    s_mov_b64 exec, -1
    s_branch L_qjoin
L_qwave:
    s_mov_b32 s84, s68
    s_and_b32 s85, s69, 0xffff
    s_mov_b32 s86, 8192
    s_mov_b32 s87, 0x00020000
    s_mov_b32 s88, s74
    s_and_b32 s89, s75, 0xffff
    s_mov_b32 s90, 4194304
    s_mov_b32 s91, 0x00020000
    s_lshr_b32 s83, s80, 2
    s_and_b32 s92, s80, 3
    s_lshl_b32 s93, s78, 2
    s_add_u32 s92, s92, s93
    v_lshlrev_b32 v8, 10, v232
    v_lshl_add_u32 v8, v233, 4, v8
    s_lshl_b32 s17, s83, 8
    buffer_load_dwordx4 v[12:15], v8, s[84:87], s17 offen offset:0
    buffer_load_dwordx4 v[16:19], v8, s[84:87], s17 offen offset:64
    buffer_load_dwordx4 v[20:23], v8, s[84:87], s17 offen offset:128
    buffer_load_dwordx4 v[24:27], v8, s[84:87], s17 offen offset:192
    v_lshlrev_b32 v9, 16, v233
    v_lshl_add_u32 v9, v232, 4, v9
    s_lshl_b32 s17, s83, 20
    s_lshl_b32 s18, s92, 8
    s_add_u32 s17, s17, s18
    buffer_load_dwordx4 v[72:75], v9, s[88:91], s17 offen
    s_add_u32 s17, s17, 8192
    buffer_load_dwordx4 v[76:79], v9, s[88:91], s17 offen
    s_add_u32 s17, s17, 8192
    buffer_load_dwordx4 v[80:83], v9, s[88:91], s17 offen
    s_add_u32 s17, s17, 8192
    buffer_load_dwordx4 v[84:87], v9, s[88:91], s17 offen
    s_add_u32 s17, s17, 8192
    buffer_load_dwordx4 v[88:91], v9, s[88:91], s17 offen
    s_add_u32 s17, s17, 8192
    buffer_load_dwordx4 v[92:95], v9, s[88:91], s17 offen
    s_add_u32 s17, s17, 8192
    buffer_load_dwordx4 v[96:99], v9, s[88:91], s17 offen
    s_add_u32 s17, s17, 8192
    buffer_load_dwordx4 v[100:103], v9, s[88:91], s17 offen
    s_add_u32 s17, s17, 8192
    s_add_u32 s17, s17, 196608
    buffer_load_dwordx4 v[104:107], v9, s[88:91], s17 offen
    s_add_u32 s17, s17, 8192
    buffer_load_dwordx4 v[108:111], v9, s[88:91], s17 offen
    s_add_u32 s17, s17, 8192
    buffer_load_dwordx4 v[112:115], v9, s[88:91], s17 offen
    s_add_u32 s17, s17, 8192
    buffer_load_dwordx4 v[116:119], v9, s[88:91], s17 offen
    s_add_u32 s17, s17, 8192
    buffer_load_dwordx4 v[120:123], v9, s[88:91], s17 offen
    s_add_u32 s17, s17, 8192
    buffer_load_dwordx4 v[124:127], v9, s[88:91], s17 offen
    s_add_u32 s17, s17, 8192
    buffer_load_dwordx4 v[128:131], v9, s[88:91], s17 offen
    s_add_u32 s17, s17, 8192
    buffer_load_dwordx4 v[132:135], v9, s[88:91], s17 offen
    s_add_u32 s17, s17, 8192
    s_add_u32 s17, s17, 196608
    buffer_load_dwordx4 v[136:139], v9, s[88:91], s17 offen
    s_add_u32 s17, s17, 8192
    buffer_load_dwordx4 v[140:143], v9, s[88:91], s17 offen
    s_add_u32 s17, s17, 8192
    buffer_load_dwordx4 v[144:147], v9, s[88:91], s17 offen
    s_add_u32 s17, s17, 8192
    buffer_load_dwordx4 v[148:151], v9, s[88:91], s17 offen
    s_add_u32 s17, s17, 8192
    buffer_load_dwordx4 v[152:155], v9, s[88:91], s17 offen
    s_add_u32 s17, s17, 8192
    buffer_load_dwordx4 v[156:159], v9, s[88:91], s17 offen
    s_add_u32 s17, s17, 8192
    buffer_load_dwordx4 v[160:163], v9, s[88:91], s17 offen
    s_add_u32 s17, s17, 8192
    buffer_load_dwordx4 v[164:167], v9, s[88:91], s17 offen
    s_add_u32 s17, s17, 8192
    s_add_u32 s17, s17, 196608
    buffer_load_dwordx4 v[168:171], v9, s[88:91], s17 offen
    s_add_u32 s17, s17, 8192
    buffer_load_dwordx4 v[172:175], v9, s[88:91], s17 offen
    s_add_u32 s17, s17, 8192
    buffer_load_dwordx4 v[176:179], v9, s[88:91], s17 offen
    s_add_u32 s17, s17, 8192
    buffer_load_dwordx4 v[180:183], v9, s[88:91], s17 offen
    s_add_u32 s17, s17, 8192
    buffer_load_dwordx4 v[184:187], v9, s[88:91], s17 offen
    s_add_u32 s17, s17, 8192
    buffer_load_dwordx4 v[188:191], v9, s[88:91], s17 offen
    s_add_u32 s17, s17, 8192
    buffer_load_dwordx4 v[192:195], v9, s[88:91], s17 offen
    s_add_u32 s17, s17, 8192
    buffer_load_dwordx4 v[196:199], v9, s[88:91], s17 offen
    s_add_u32 s17, s17, 8192
    s_mov_b64 exec, 3
    v_lshlrev_b32 v10, 6, v11
    buffer_store_dword v234, v10, s[28:31], s46 offen sc1
    s_mov_b64 exec, 1
    v_mov_b32 v10, 8
    ds_write_b32 v234, v10 offset:17664
    s_mov_b64 exec, -1
    s_waitcnt vmcnt(25)
    s_barrier
    v_perm_b32 v200, v76, v72, s40
    v_perm_b32 v201, v84, v80, s40
    v_perm_b32 v202, v92, v88, s40
    v_perm_b32 v203, v100, v96, s40
    v_perm_b32 v204, v76, v72, s41
    v_perm_b32 v205, v84, v80, s41
    v_perm_b32 v206, v92, v88, s41
    v_perm_b32 v207, v100, v96, s41
    v_mfma_f32_16x16x32_bf16 v[40:43], v[12:15], v[200:203], 0
    v_perm_b32 v208, v77, v73, s40
    v_perm_b32 v209, v85, v81, s40
    v_perm_b32 v210, v93, v89, s40
    v_perm_b32 v211, v101, v97, s40
    v_mfma_f32_16x16x32_bf16 v[44:47], v[12:15], v[204:207], 0
    v_perm_b32 v212, v77, v73, s41
    v_perm_b32 v213, v85, v81, s41
    v_perm_b32 v214, v93, v89, s41
    v_perm_b32 v215, v101, v97, s41
    v_mfma_f32_16x16x32_bf16 v[48:51], v[12:15], v[208:211], 0
    v_perm_b32 v216, v78, v74, s40
    v_perm_b32 v217, v86, v82, s40
    v_perm_b32 v218, v94, v90, s40
    v_perm_b32 v219, v102, v98, s40
    v_mfma_f32_16x16x32_bf16 v[52:55], v[12:15], v[212:215], 0
    v_perm_b32 v220, v78, v74, s41
    v_perm_b32 v221, v86, v82, s41
    v_perm_b32 v222, v94, v90, s41
    v_perm_b32 v223, v102, v98, s41
    v_mfma_f32_16x16x32_bf16 v[56:59], v[12:15], v[216:219], 0
    v_perm_b32 v224, v79, v75, s40
    v_perm_b32 v225, v87, v83, s40
    v_perm_b32 v226, v95, v91, s40
    v_perm_b32 v227, v103, v99, s40
    v_mfma_f32_16x16x32_bf16 v[60:63], v[12:15], v[220:223], 0
    v_perm_b32 v228, v79, v75, s41
    v_perm_b32 v229, v87, v83, s41
    v_perm_b32 v230, v95, v91, s41
    v_perm_b32 v231, v103, v99, s41
    v_mfma_f32_16x16x32_bf16 v[64:67], v[12:15], v[224:227], 0
    s_nop 1
    v_mfma_f32_16x16x32_bf16 v[68:71], v[12:15], v[228:231], 0
    s_waitcnt vmcnt(17)
    v_perm_b32 v200, v108, v104, s40
    v_perm_b32 v201, v116, v112, s40
    v_perm_b32 v202, v124, v120, s40
    v_perm_b32 v203, v132, v128, s40
    v_perm_b32 v204, v108, v104, s41
    v_perm_b32 v205, v116, v112, s41
    v_perm_b32 v206, v124, v120, s41
    v_perm_b32 v207, v132, v128, s41
    v_mfma_f32_16x16x32_bf16 v[40:43], v[16:19], v[200:203], v[40:43]
    v_perm_b32 v208, v109, v105, s40
    v_perm_b32 v209, v117, v113, s40
    v_perm_b32 v210, v125, v121, s40
    v_perm_b32 v211, v133, v129, s40
    v_mfma_f32_16x16x32_bf16 v[44:47], v[16:19], v[204:207], v[44:47]
    v_perm_b32 v212, v109, v105, s41
    v_perm_b32 v213, v117, v113, s41
    v_perm_b32 v214, v125, v121, s41
    v_perm_b32 v215, v133, v129, s41
    v_mfma_f32_16x16x32_bf16 v[48:51], v[16:19], v[208:211], v[48:51]
    v_perm_b32 v216, v110, v106, s40
    v_perm_b32 v217, v118, v114, s40
    v_perm_b32 v218, v126, v122, s40
    v_perm_b32 v219, v134, v130, s40
    v_mfma_f32_16x16x32_bf16 v[52:55], v[16:19], v[212:215], v[52:55]
    v_perm_b32 v220, v110, v106, s41
    v_perm_b32 v221, v118, v114, s41
    v_perm_b32 v222, v126, v122, s41
    v_perm_b32 v223, v134, v130, s41
    v_mfma_f32_16x16x32_bf16 v[56:59], v[16:19], v[216:219], v[56:59]
    v_perm_b32 v224, v111, v107, s40
    v_perm_b32 v225, v119, v115, s40
    v_perm_b32 v226, v127, v123, s40
    v_perm_b32 v227, v135, v131, s40
    v_mfma_f32_16x16x32_bf16 v[60:63], v[16:19], v[220:223], v[60:63]
    v_perm_b32 v228, v111, v107, s41
    v_perm_b32 v229, v119, v115, s41
    v_perm_b32 v230, v127, v123, s41
    v_perm_b32 v231, v135, v131, s41
    v_mfma_f32_16x16x32_bf16 v[64:67], v[16:19], v[224:227], v[64:67]
    s_nop 1
    v_mfma_f32_16x16x32_bf16 v[68:71], v[16:19], v[228:231], v[68:71]
    s_waitcnt vmcnt(9)
    v_perm_b32 v200, v140, v136, s40
    v_perm_b32 v201, v148, v144, s40
    v_perm_b32 v202, v156, v152, s40
    v_perm_b32 v203, v164, v160, s40
    v_perm_b32 v204, v140, v136, s41
    v_perm_b32 v205, v148, v144, s41
    v_perm_b32 v206, v156, v152, s41
    v_perm_b32 v207, v164, v160, s41
    v_mfma_f32_16x16x32_bf16 v[40:43], v[20:23], v[200:203], v[40:43]
    v_perm_b32 v208, v141, v137, s40
    v_perm_b32 v209, v149, v145, s40
    v_perm_b32 v210, v157, v153, s40
    v_perm_b32 v211, v165, v161, s40
    v_mfma_f32_16x16x32_bf16 v[44:47], v[20:23], v[204:207], v[44:47]
    v_perm_b32 v212, v141, v137, s41
    v_perm_b32 v213, v149, v145, s41
    v_perm_b32 v214, v157, v153, s41
    v_perm_b32 v215, v165, v161, s41
    v_mfma_f32_16x16x32_bf16 v[48:51], v[20:23], v[208:211], v[48:51]
    v_perm_b32 v216, v142, v138, s40
    v_perm_b32 v217, v150, v146, s40
    v_perm_b32 v218, v158, v154, s40
    v_perm_b32 v219, v166, v162, s40
    v_mfma_f32_16x16x32_bf16 v[52:55], v[20:23], v[212:215], v[52:55]
    v_perm_b32 v220, v142, v138, s41
    v_perm_b32 v221, v150, v146, s41
    v_perm_b32 v222, v158, v154, s41
    v_perm_b32 v223, v166, v162, s41
    v_mfma_f32_16x16x32_bf16 v[56:59], v[20:23], v[216:219], v[56:59]
    v_perm_b32 v224, v143, v139, s40
    v_perm_b32 v225, v151, v147, s40
    v_perm_b32 v226, v159, v155, s40
    v_perm_b32 v227, v167, v163, s40
    v_mfma_f32_16x16x32_bf16 v[60:63], v[20:23], v[220:223], v[60:63]
    v_perm_b32 v228, v143, v139, s41
    v_perm_b32 v229, v151, v147, s41
    v_perm_b32 v230, v159, v155, s41
    v_perm_b32 v231, v167, v163, s41
    v_mfma_f32_16x16x32_bf16 v[64:67], v[20:23], v[224:227], v[64:67]
    s_nop 1
    v_mfma_f32_16x16x32_bf16 v[68:71], v[20:23], v[228:231], v[68:71]
    s_waitcnt vmcnt(1)
    v_perm_b32 v200, v172, v168, s40
    v_perm_b32 v201, v180, v176, s40
    v_perm_b32 v202, v188, v184, s40
    v_perm_b32 v203, v196, v192, s40
    v_perm_b32 v204, v172, v168, s41
    v_perm_b32 v205, v180, v176, s41
    v_perm_b32 v206, v188, v184, s41
    v_perm_b32 v207, v196, v192, s41
    v_mfma_f32_16x16x32_bf16 v[40:43], v[24:27], v[200:203], v[40:43]
    v_perm_b32 v208, v173, v169, s40
    v_perm_b32 v209, v181, v177, s40
    v_perm_b32 v210, v189, v185, s40
    v_perm_b32 v211, v197, v193, s40
    v_mfma_f32_16x16x32_bf16 v[44:47], v[24:27], v[204:207], v[44:47]
    v_perm_b32 v212, v173, v169, s41
    v_perm_b32 v213, v181, v177, s41
    v_perm_b32 v214, v189, v185, s41
    v_perm_b32 v215, v197, v193, s41
    v_mfma_f32_16x16x32_bf16 v[48:51], v[24:27], v[208:211], v[48:51]
    v_perm_b32 v216, v174, v170, s40
    v_perm_b32 v217, v182, v178, s40
    v_perm_b32 v218, v190, v186, s40
    v_perm_b32 v219, v198, v194, s40
    v_mfma_f32_16x16x32_bf16 v[52:55], v[24:27], v[212:215], v[52:55]
    v_perm_b32 v220, v174, v170, s41
    v_perm_b32 v221, v182, v178, s41
    v_perm_b32 v222, v190, v186, s41
    v_perm_b32 v223, v198, v194, s41
    v_mfma_f32_16x16x32_bf16 v[56:59], v[24:27], v[216:219], v[56:59]
    v_perm_b32 v224, v175, v171, s40
    v_perm_b32 v225, v183, v179, s40
    v_perm_b32 v226, v191, v187, s40
    v_perm_b32 v227, v199, v195, s40
    v_mfma_f32_16x16x32_bf16 v[60:63], v[24:27], v[220:223], v[60:63]
    v_perm_b32 v228, v175, v171, s41
    v_perm_b32 v229, v183, v179, s41
    v_perm_b32 v230, v191, v187, s41
    v_perm_b32 v231, v199, v195, s41
    v_mfma_f32_16x16x32_bf16 v[64:67], v[24:27], v[224:227], v[64:67]
    s_nop 1
    v_mfma_f32_16x16x32_bf16 v[68:71], v[24:27], v[228:231], v[68:71]
    v_lshlrev_b32 v8, 16, v233
    v_lshl_add_u32 v8, v232, 5, v8
    s_lshl_b32 s18, s83, 1
    s_add_u32 s18, s18, s3
    s_lshl_b32 s18, s18, 17
    s_lshl_b32 s19, s92, 9
    s_add_u32 s18, s18, s19
    s_add_u32 s18, s18, 0
    s_nop 3
    v_mov_b32 v200, v40
    v_mov_b32 v201, v44
    v_mov_b32 v202, v48
    v_mov_b32 v203, v52
    v_mov_b32 v204, v56
    v_mov_b32 v205, v60
    v_mov_b32 v206, v64
    v_mov_b32 v207, v68
    v_mov_b32 v208, v41
    v_mov_b32 v209, v45
    v_mov_b32 v210, v49
    v_mov_b32 v211, v53
    v_mov_b32 v212, v57
    v_mov_b32 v213, v61
    v_mov_b32 v214, v65
    v_mov_b32 v215, v69
    v_mov_b32 v216, v42
    v_mov_b32 v217, v46
    v_mov_b32 v218, v50
    v_mov_b32 v219, v54
    v_mov_b32 v220, v58
    v_mov_b32 v221, v62
    v_mov_b32 v222, v66
    v_mov_b32 v223, v70
    v_mov_b32 v224, v43
    v_mov_b32 v225, v47
    v_mov_b32 v226, v51
    v_mov_b32 v227, v55
    v_mov_b32 v228, v59
    v_mov_b32 v229, v63
    v_mov_b32 v230, v67
    v_mov_b32 v231, v71
    s_mov_b32 exec_lo, -1
    s_mov_b32 exec_hi, 0
    buffer_store_dwordx4 v[200:203], v8, s[28:31], s18 offen sc1
    buffer_store_dwordx4 v[204:207], v8, s[28:31], s18 offen offset:16 sc1
    s_add_u32 s18, s18, 16384
    buffer_store_dwordx4 v[208:211], v8, s[28:31], s18 offen sc1
    buffer_store_dwordx4 v[212:215], v8, s[28:31], s18 offen offset:16 sc1
    s_add_u32 s18, s18, 16384
    buffer_store_dwordx4 v[216:219], v8, s[28:31], s18 offen sc1
    buffer_store_dwordx4 v[220:223], v8, s[28:31], s18 offen offset:16 sc1
    s_add_u32 s18, s18, 16384
    buffer_store_dwordx4 v[224:227], v8, s[28:31], s18 offen sc1
    buffer_store_dwordx4 v[228:231], v8, s[28:31], s18 offen offset:16 sc1
    s_mov_b64 exec, 1
    v_mov_b32 v8, 1
    s_add_u32 s17, s82, 16
    s_waitcnt vmcnt(0)
    buffer_atomic_add v8, v234, s[60:63], s17 offen sc0
    s_waitcnt vmcnt(0)
    s_mov_b64 exec, -1
    v_readfirstlane_b32 s39, v8
    s_and_b32 s39, s39, 15
    s_cmp_lg_u32 s39, 15
    s_cbranch_scc1 L_waitq
    v_lshrrev_b32 v8, 1, v11
    v_lshlrev_b32 v8, 4, v8
    v_and_b32 v9, 1, v11
    v_add_u32 v8, v8, v9
    v_lshlrev_b32 v8, 7, v8
    s_lshl_b32 s17, s3, 7
    s_lshl_b32 s18, s78, 1
    s_add_u32 s17, s17, s18
    s_lshl_b32 s17, s17, 7
    s_add_u32 s17, s17, 2195456
    s_mov_b64 exec, 0xffff
    buffer_store_dword v237, v8, s[28:31], s17 offen offset:64 sc1
    s_mov_b64 exec, -1
    s_branch L_qflagdone
L_waitq:
    s_add_u32 s17, s46, 64
    s_mov_b32 s38, 400000
L_poll_q:
    buffer_load_dword v9, v234, s[28:31], s17 offen sc1
    s_waitcnt vmcnt(0)
    v_readfirstlane_b32 s39, v9
    s_cmp_ge_u32 s39, 1
    s_cbranch_scc1 L_polld_q
    s_sleep 4
    s_sub_u32 s38, s38, 1
    s_cmp_lg_u32 s38, 0
    s_cbranch_scc1 L_poll_q
L_polld_q:
L_qflagdone:
    s_lshl_b32 s18, s14, 11
    s_lshl_b32 s19, s3, 17
    s_add_u32 s18, s18, s19
    s_add_u32 s18, s18, 0
    v_lshlrev_b32 v8, 5, v11
    buffer_load_dwordx4 v[200:203], v8, s[28:31], s18 offen sc1
    buffer_load_dwordx4 v[204:207], v8, s[28:31], s18 offen offset:16 sc1
    s_add_u32 s18, s18, 0x40000
    buffer_load_dwordx4 v[208:211], v8, s[28:31], s18 offen sc1
    buffer_load_dwordx4 v[212:215], v8, s[28:31], s18 offen offset:16 sc1
    s_add_u32 s18, s18, 0x40000
    buffer_load_dwordx4 v[216:219], v8, s[28:31], s18 offen sc1
    buffer_load_dwordx4 v[220:223], v8, s[28:31], s18 offen offset:16 sc1
    s_add_u32 s18, s18, 0x40000
    buffer_load_dwordx4 v[224:227], v8, s[28:31], s18 offen sc1
    buffer_load_dwordx4 v[228:231], v8, s[28:31], s18 offen offset:16 sc1
    s_waitcnt vmcnt(0)
    v_add_f32 v200, v200, v208
    v_add_f32 v216, v216, v224
    v_add_f32 v201, v201, v209
    v_add_f32 v217, v217, v225
    v_add_f32 v202, v202, v210
    v_add_f32 v218, v218, v226
    v_add_f32 v203, v203, v211
    v_add_f32 v219, v219, v227
    v_add_f32 v204, v204, v212
    v_add_f32 v220, v220, v228
    v_add_f32 v205, v205, v213
    v_add_f32 v221, v221, v229
    v_add_f32 v206, v206, v214
    v_add_f32 v222, v222, v230
    v_add_f32 v207, v207, v215
    v_add_f32 v223, v223, v231
    v_add_f32 v200, v200, v216
    v_add_f32 v201, v201, v217
    v_add_f32 v202, v202, v218
    v_add_f32 v203, v203, v219
    v_add_f32 v204, v204, v220
    v_add_f32 v205, v205, v221
    v_add_f32 v206, v206, v222
    v_add_f32 v207, v207, v223
    v_cvt_pk_bf16_f32 v200, v200, v201
    v_cvt_pk_bf16_f32 v201, v202, v203
    v_cvt_pk_bf16_f32 v202, v204, v205
    v_cvt_pk_bf16_f32 v203, v206, v207
    v_lshlrev_b32 v8, 4, v11
    ds_write_b128 v8, v[200:203] offset:16640
    s_waitcnt lgkmcnt(0)
L_qjoin:
    s_barrier
    s_lshr_b32 s94, s80, 2
    s_lshl_b32 s93, s78, 2
    s_add_u32 s94, s94, s93
    s_and_b32 s95, s80, 3
    s_cmp_lt_u32 s16, 4
    s_cbranch_scc1 L_helper
    v_mov_b32 v40, 0
    v_mov_b32 v41, 0
    v_mov_b32 v42, 0
    v_mov_b32 v43, 0
    v_mov_b32 v44, 0
    v_mov_b32 v45, 0
    v_mov_b32 v46, 0
    v_mov_b32 v47, 0
    v_mov_b32 v48, 0
    v_mov_b32 v49, 0
    v_mov_b32 v50, 0
    v_mov_b32 v51, 0
    v_mov_b32 v52, 0
    v_mov_b32 v53, 0
    v_mov_b32 v54, 0
    v_mov_b32 v55, 0
    v_mov_b32 v56, 0
    v_mov_b32 v57, 0
    v_mov_b32 v58, 0
    v_mov_b32 v59, 0
    v_mov_b32 v60, 0
    v_mov_b32 v61, 0
    v_mov_b32 v62, 0
    v_mov_b32 v63, 0
    v_mov_b32 v64, 0
    v_mov_b32 v65, 0
    v_mov_b32 v66, 0
    v_mov_b32 v67, 0
    v_mov_b32 v68, 0
    v_mov_b32 v69, 0
    v_mov_b32 v70, 0
    v_mov_b32 v71, 0
    v_mov_b32 v12, 0
    v_mov_b32 v13, 0
    v_mov_b32 v14, 0
    v_mov_b32 v15, 0
    v_mov_b32 v16, 0
    v_mov_b32 v17, 0
    v_mov_b32 v18, 0
    v_mov_b32 v19, 0
    v_mov_b32 v20, 0
    v_mov_b32 v21, 0
    v_mov_b32 v22, 0
    v_mov_b32 v23, 0
    v_mov_b32 v24, 0
    v_mov_b32 v25, 0
    v_mov_b32 v26, 0
    v_mov_b32 v27, 0
    v_lshlrev_b32 v8, 8, v232
    v_lshl_add_u32 v8, v233, 4, v8
    v_cmp_gt_u32 vcc, 4, v232
    s_and_saveexec_b64 s[34:35], vcc
    ds_read_b128 v[12:15], v8 offset:16640
    ds_read_b128 v[16:19], v8 offset:16704
    ds_read_b128 v[20:23], v8 offset:16768
    ds_read_b128 v[24:27], v8 offset:16832
    s_mov_b64 exec, s[34:35]
    v_mov_b32 v5, 0xff800000
    v_mov_b32 v6, 0
    v_mov_b32 v7, 0
    s_waitcnt lgkmcnt(0)
    s_mov_b32 s97, 0
L_loop:
    s_cmp_ge_u32 s44, 128
    s_cbranch_scc1 L_loopend
    s_mov_b64 exec, 1
    ds_add_rtn_u32 v236, v234, v237 offset:17664
    s_mov_b64 exec, -1
    s_waitcnt vmcnt(24)
    v_mfma_f32_16x16x32_bf16 v[28:31], v[72:75], v[12:15], 0
    v_mfma_f32_16x16x32_bf16 v[32:35], v[88:91], v[12:15], 0
    v_mfma_f32_16x16x32_bf16 v[28:31], v[76:79], v[16:19], v[28:31]
    v_mfma_f32_16x16x32_bf16 v[32:35], v[92:95], v[16:19], v[32:35]
    v_mfma_f32_16x16x32_bf16 v[28:31], v[80:83], v[20:23], v[28:31]
    v_mfma_f32_16x16x32_bf16 v[32:35], v[96:99], v[20:23], v[32:35]
    v_mfma_f32_16x16x32_bf16 v[28:31], v[84:87], v[24:27], v[28:31]
    v_mfma_f32_16x16x32_bf16 v[32:35], v[100:103], v[24:27], v[32:35]
    s_waitcnt lgkmcnt(0)
    v_readfirstlane_b32 s44, v236
    s_lshl_b32 s47, s44, 13
    s_cmp_ge_u32 s44, 128
    s_cselect_b32 s47, 0x40000000, s47
    buffer_load_dwordx4 v[72:75], v1, s[20:23], s47 offen offset:0 nt
    buffer_load_dwordx4 v[76:79], v1, s[20:23], s47 offen offset:64 nt
    buffer_load_dwordx4 v[80:83], v1, s[20:23], s47 offen offset:128 nt
    buffer_load_dwordx4 v[84:87], v1, s[20:23], s47 offen offset:192 nt
    buffer_load_dwordx4 v[88:91], v2, s[20:23], s47 offen offset:0 nt
    buffer_load_dwordx4 v[92:95], v2, s[20:23], s47 offen offset:64 nt
    buffer_load_dwordx4 v[96:99], v2, s[20:23], s47 offen offset:128 nt
    buffer_load_dwordx4 v[100:103], v2, s[20:23], s47 offen offset:192 nt
    v_max3_f32 v8, v28, v29, v30
    v_max3_f32 v8, v8, v31, v32
    v_max3_f32 v8, v8, v33, v34
    v_max3_f32 v8, v8, v35, v5
    v_mov_b32 v9, v8
    s_nop 1
    v_permlane16_swap_b32 v8, v9
    s_nop 0
    v_max_f32 v8, v8, v9
    v_mov_b32 v9, v8
    s_nop 1
    v_permlane32_swap_b32 v8, v9
    s_nop 0
    v_max_f32 v8, v8, v9
    v_cmp_gt_f32 vcc, v8, v5
    s_cbranch_vccz L_skip0
    v_sub_f32 v10, v5, v8
    v_mul_f32 v10, s42, v10
    v_exp_f32 v10, v10
    v_mov_b32 v5, v8
    v_mul_f32 v7, s42, v8
    v_mul_f32 v6, v6, v10
    v_readlane_b32 s48, v10, 0
    v_readlane_b32 s49, v10, 1
    v_readlane_b32 s50, v10, 2
    v_readlane_b32 s51, v10, 3
    s_nop 1
    v_mul_f32 v40, s48, v40
    v_mul_f32 v41, s49, v41
    v_mul_f32 v42, s50, v42
    v_mul_f32 v43, s51, v43
    v_mul_f32 v44, s48, v44
    v_mul_f32 v45, s49, v45
    v_mul_f32 v46, s50, v46
    v_mul_f32 v47, s51, v47
    v_mul_f32 v48, s48, v48
    v_mul_f32 v49, s49, v49
    v_mul_f32 v50, s50, v50
    v_mul_f32 v51, s51, v51
    v_mul_f32 v52, s48, v52
    v_mul_f32 v53, s49, v53
    v_mul_f32 v54, s50, v54
    v_mul_f32 v55, s51, v55
    v_mul_f32 v56, s48, v56
    v_mul_f32 v57, s49, v57
    v_mul_f32 v58, s50, v58
    v_mul_f32 v59, s51, v59
    v_mul_f32 v60, s48, v60
    v_mul_f32 v61, s49, v61
    v_mul_f32 v62, s50, v62
    v_mul_f32 v63, s51, v63
    v_mul_f32 v64, s48, v64
    v_mul_f32 v65, s49, v65
    v_mul_f32 v66, s50, v66
    v_mul_f32 v67, s51, v67
    v_mul_f32 v68, s48, v68
    v_mul_f32 v69, s49, v69
    v_mul_f32 v70, s50, v70
    v_mul_f32 v71, s51, v71
L_skip0:
    v_fma_f32 v28, v28, s42, -v7
    v_fma_f32 v29, v29, s42, -v7
    v_fma_f32 v30, v30, s42, -v7
    v_fma_f32 v31, v31, s42, -v7
    v_fma_f32 v32, v32, s42, -v7
    v_fma_f32 v33, v33, s42, -v7
    v_fma_f32 v34, v34, s42, -v7
    v_fma_f32 v35, v35, s42, -v7
    v_exp_f32 v28, v28
    v_exp_f32 v29, v29
    v_exp_f32 v30, v30
    v_exp_f32 v31, v31
    v_exp_f32 v32, v32
    v_exp_f32 v33, v33
    v_exp_f32 v34, v34
    v_exp_f32 v35, v35
    s_nop 0
    v_add_f32 v8, v28, v29
    v_add_f32 v9, v30, v31
    v_add_f32 v10, v32, v33
    v_add_f32 v6, v6, v8
    v_add_f32 v8, v34, v35
    v_add_f32 v9, v9, v10
    v_add_f32 v6, v6, v8
    v_add_f32 v6, v6, v9
    v_cvt_pk_bf16_f32 v36, v28, v29
    v_cvt_pk_bf16_f32 v37, v30, v31
    v_cvt_pk_bf16_f32 v38, v32, v33
    v_cvt_pk_bf16_f32 v39, v34, v35
    s_waitcnt vmcnt(24)
    v_perm_b32 v200, v140, v136, s40
    v_perm_b32 v201, v148, v144, s40
    v_perm_b32 v202, v156, v152, s40
    v_perm_b32 v203, v164, v160, s40
    v_perm_b32 v204, v140, v136, s41
    v_perm_b32 v205, v148, v144, s41
    v_perm_b32 v206, v156, v152, s41
    v_perm_b32 v207, v164, v160, s41
    v_mfma_f32_16x16x32_bf16 v[40:43], v[36:39], v[200:203], v[40:43]
    v_perm_b32 v208, v141, v137, s40
    v_perm_b32 v209, v149, v145, s40
    v_perm_b32 v210, v157, v153, s40
    v_perm_b32 v211, v165, v161, s40
    v_mfma_f32_16x16x32_bf16 v[44:47], v[36:39], v[204:207], v[44:47]
    v_perm_b32 v212, v141, v137, s41
    v_perm_b32 v213, v149, v145, s41
    v_perm_b32 v214, v157, v153, s41
    v_perm_b32 v215, v165, v161, s41
    v_mfma_f32_16x16x32_bf16 v[48:51], v[36:39], v[208:211], v[48:51]
    v_perm_b32 v216, v142, v138, s40
    v_perm_b32 v217, v150, v146, s40
    v_perm_b32 v218, v158, v154, s40
    v_perm_b32 v219, v166, v162, s40
    v_mfma_f32_16x16x32_bf16 v[52:55], v[36:39], v[212:215], v[52:55]
    v_perm_b32 v220, v142, v138, s41
    v_perm_b32 v221, v150, v146, s41
    v_perm_b32 v222, v158, v154, s41
    v_perm_b32 v223, v166, v162, s41
    v_mfma_f32_16x16x32_bf16 v[56:59], v[36:39], v[216:219], v[56:59]
    v_perm_b32 v224, v143, v139, s40
    v_perm_b32 v225, v151, v147, s40
    v_perm_b32 v226, v159, v155, s40
    v_perm_b32 v227, v167, v163, s40
    v_mfma_f32_16x16x32_bf16 v[60:63], v[36:39], v[220:223], v[60:63]
    v_perm_b32 v228, v143, v139, s41
    v_perm_b32 v229, v151, v147, s41
    v_perm_b32 v230, v159, v155, s41
    v_perm_b32 v231, v167, v163, s41
    v_mfma_f32_16x16x32_bf16 v[64:67], v[36:39], v[224:227], v[64:67]
    s_nop 1
    v_mfma_f32_16x16x32_bf16 v[68:71], v[36:39], v[228:231], v[68:71]
    buffer_load_dwordx4 v[136:139], v3, s[24:27], s47 offen offset:0 nt
    buffer_load_dwordx4 v[140:143], v3, s[24:27], s47 offen offset:1024 nt
    buffer_load_dwordx4 v[144:147], v3, s[24:27], s47 offen offset:2048 nt
    buffer_load_dwordx4 v[148:151], v3, s[24:27], s47 offen offset:3072 nt
    buffer_load_dwordx4 v[152:155], v4, s[24:27], s47 offen offset:0 nt
    buffer_load_dwordx4 v[156:159], v4, s[24:27], s47 offen offset:1024 nt
    buffer_load_dwordx4 v[160:163], v4, s[24:27], s47 offen offset:2048 nt
    buffer_load_dwordx4 v[164:167], v4, s[24:27], s47 offen offset:3072 nt
    s_cmp_ge_u32 s45, 128
    s_cbranch_scc1 L_loopend
    s_mov_b64 exec, 1
    ds_add_rtn_u32 v236, v234, v237 offset:17664
    s_mov_b64 exec, -1
    s_waitcnt vmcnt(24)
    v_mfma_f32_16x16x32_bf16 v[28:31], v[104:107], v[12:15], 0
    v_mfma_f32_16x16x32_bf16 v[32:35], v[120:123], v[12:15], 0
    v_mfma_f32_16x16x32_bf16 v[28:31], v[108:111], v[16:19], v[28:31]
    v_mfma_f32_16x16x32_bf16 v[32:35], v[124:127], v[16:19], v[32:35]
    v_mfma_f32_16x16x32_bf16 v[28:31], v[112:115], v[20:23], v[28:31]
    v_mfma_f32_16x16x32_bf16 v[32:35], v[128:131], v[20:23], v[32:35]
    v_mfma_f32_16x16x32_bf16 v[28:31], v[116:119], v[24:27], v[28:31]
    v_mfma_f32_16x16x32_bf16 v[32:35], v[132:135], v[24:27], v[32:35]
    s_waitcnt lgkmcnt(0)
    v_readfirstlane_b32 s45, v236
    s_lshl_b32 s47, s45, 13
    s_cmp_ge_u32 s45, 128
    s_cselect_b32 s47, 0x40000000, s47
    buffer_load_dwordx4 v[104:107], v1, s[20:23], s47 offen offset:0 nt
    buffer_load_dwordx4 v[108:111], v1, s[20:23], s47 offen offset:64 nt
    buffer_load_dwordx4 v[112:115], v1, s[20:23], s47 offen offset:128 nt
    buffer_load_dwordx4 v[116:119], v1, s[20:23], s47 offen offset:192 nt
    buffer_load_dwordx4 v[120:123], v2, s[20:23], s47 offen offset:0 nt
    buffer_load_dwordx4 v[124:127], v2, s[20:23], s47 offen offset:64 nt
    buffer_load_dwordx4 v[128:131], v2, s[20:23], s47 offen offset:128 nt
    buffer_load_dwordx4 v[132:135], v2, s[20:23], s47 offen offset:192 nt
    v_max3_f32 v8, v28, v29, v30
    v_max3_f32 v8, v8, v31, v32
    v_max3_f32 v8, v8, v33, v34
    v_max3_f32 v8, v8, v35, v5
    v_mov_b32 v9, v8
    s_nop 1
    v_permlane16_swap_b32 v8, v9
    s_nop 0
    v_max_f32 v8, v8, v9
    v_mov_b32 v9, v8
    s_nop 1
    v_permlane32_swap_b32 v8, v9
    s_nop 0
    v_max_f32 v8, v8, v9
    v_cmp_gt_f32 vcc, v8, v5
    s_cbranch_vccz L_skip1
    v_sub_f32 v10, v5, v8
    v_mul_f32 v10, s42, v10
    v_exp_f32 v10, v10
    v_mov_b32 v5, v8
    v_mul_f32 v7, s42, v8
    v_mul_f32 v6, v6, v10
    v_readlane_b32 s48, v10, 0
    v_readlane_b32 s49, v10, 1
    v_readlane_b32 s50, v10, 2
    v_readlane_b32 s51, v10, 3
    s_nop 1
    v_mul_f32 v40, s48, v40
    v_mul_f32 v41, s49, v41
    v_mul_f32 v42, s50, v42
    v_mul_f32 v43, s51, v43
    v_mul_f32 v44, s48, v44
    v_mul_f32 v45, s49, v45
    v_mul_f32 v46, s50, v46
    v_mul_f32 v47, s51, v47
    v_mul_f32 v48, s48, v48
    v_mul_f32 v49, s49, v49
    v_mul_f32 v50, s50, v50
    v_mul_f32 v51, s51, v51
    v_mul_f32 v52, s48, v52
    v_mul_f32 v53, s49, v53
    v_mul_f32 v54, s50, v54
    v_mul_f32 v55, s51, v55
    v_mul_f32 v56, s48, v56
    v_mul_f32 v57, s49, v57
    v_mul_f32 v58, s50, v58
    v_mul_f32 v59, s51, v59
    v_mul_f32 v60, s48, v60
    v_mul_f32 v61, s49, v61
    v_mul_f32 v62, s50, v62
    v_mul_f32 v63, s51, v63
    v_mul_f32 v64, s48, v64
    v_mul_f32 v65, s49, v65
    v_mul_f32 v66, s50, v66
    v_mul_f32 v67, s51, v67
    v_mul_f32 v68, s48, v68
    v_mul_f32 v69, s49, v69
    v_mul_f32 v70, s50, v70
    v_mul_f32 v71, s51, v71
L_skip1:
    v_fma_f32 v28, v28, s42, -v7
    v_fma_f32 v29, v29, s42, -v7
    v_fma_f32 v30, v30, s42, -v7
    v_fma_f32 v31, v31, s42, -v7
    v_fma_f32 v32, v32, s42, -v7
    v_fma_f32 v33, v33, s42, -v7
    v_fma_f32 v34, v34, s42, -v7
    v_fma_f32 v35, v35, s42, -v7
    v_exp_f32 v28, v28
    v_exp_f32 v29, v29
    v_exp_f32 v30, v30
    v_exp_f32 v31, v31
    v_exp_f32 v32, v32
    v_exp_f32 v33, v33
    v_exp_f32 v34, v34
    v_exp_f32 v35, v35
    s_nop 0
    v_add_f32 v8, v28, v29
    v_add_f32 v9, v30, v31
    v_add_f32 v10, v32, v33
    v_add_f32 v6, v6, v8
    v_add_f32 v8, v34, v35
    v_add_f32 v9, v9, v10
    v_add_f32 v6, v6, v8
    v_add_f32 v6, v6, v9
    v_cvt_pk_bf16_f32 v36, v28, v29
    v_cvt_pk_bf16_f32 v37, v30, v31
    v_cvt_pk_bf16_f32 v38, v32, v33
    v_cvt_pk_bf16_f32 v39, v34, v35
    s_waitcnt vmcnt(24)
    v_perm_b32 v200, v172, v168, s40
    v_perm_b32 v201, v180, v176, s40
    v_perm_b32 v202, v188, v184, s40
    v_perm_b32 v203, v196, v192, s40
    v_perm_b32 v204, v172, v168, s41
    v_perm_b32 v205, v180, v176, s41
    v_perm_b32 v206, v188, v184, s41
    v_perm_b32 v207, v196, v192, s41
    v_mfma_f32_16x16x32_bf16 v[40:43], v[36:39], v[200:203], v[40:43]
    v_perm_b32 v208, v173, v169, s40
    v_perm_b32 v209, v181, v177, s40
    v_perm_b32 v210, v189, v185, s40
    v_perm_b32 v211, v197, v193, s40
    v_mfma_f32_16x16x32_bf16 v[44:47], v[36:39], v[204:207], v[44:47]
    v_perm_b32 v212, v173, v169, s41
    v_perm_b32 v213, v181, v177, s41
    v_perm_b32 v214, v189, v185, s41
    v_perm_b32 v215, v197, v193, s41
    v_mfma_f32_16x16x32_bf16 v[48:51], v[36:39], v[208:211], v[48:51]
    v_perm_b32 v216, v174, v170, s40
    v_perm_b32 v217, v182, v178, s40
    v_perm_b32 v218, v190, v186, s40
    v_perm_b32 v219, v198, v194, s40
    v_mfma_f32_16x16x32_bf16 v[52:55], v[36:39], v[212:215], v[52:55]
    v_perm_b32 v220, v174, v170, s41
    v_perm_b32 v221, v182, v178, s41
    v_perm_b32 v222, v190, v186, s41
    v_perm_b32 v223, v198, v194, s41
    v_mfma_f32_16x16x32_bf16 v[56:59], v[36:39], v[216:219], v[56:59]
    v_perm_b32 v224, v175, v171, s40
    v_perm_b32 v225, v183, v179, s40
    v_perm_b32 v226, v191, v187, s40
    v_perm_b32 v227, v199, v195, s40
    v_mfma_f32_16x16x32_bf16 v[60:63], v[36:39], v[220:223], v[60:63]
    v_perm_b32 v228, v175, v171, s41
    v_perm_b32 v229, v183, v179, s41
    v_perm_b32 v230, v191, v187, s41
    v_perm_b32 v231, v199, v195, s41
    v_mfma_f32_16x16x32_bf16 v[64:67], v[36:39], v[224:227], v[64:67]
    s_nop 1
    v_mfma_f32_16x16x32_bf16 v[68:71], v[36:39], v[228:231], v[68:71]
    buffer_load_dwordx4 v[168:171], v3, s[24:27], s47 offen offset:0 nt
    buffer_load_dwordx4 v[172:175], v3, s[24:27], s47 offen offset:1024 nt
    buffer_load_dwordx4 v[176:179], v3, s[24:27], s47 offen offset:2048 nt
    buffer_load_dwordx4 v[180:183], v3, s[24:27], s47 offen offset:3072 nt
    buffer_load_dwordx4 v[184:187], v4, s[24:27], s47 offen offset:0 nt
    buffer_load_dwordx4 v[188:191], v4, s[24:27], s47 offen offset:1024 nt
    buffer_load_dwordx4 v[192:195], v4, s[24:27], s47 offen offset:2048 nt
    buffer_load_dwordx4 v[196:199], v4, s[24:27], s47 offen offset:3072 nt
    s_branch L_loop
L_loopend:
    v_mov_b32 v8, v6
    v_mov_b32 v9, v6
    s_nop 1
    v_permlane16_swap_b32 v8, v9
    s_nop 0
    v_add_f32 v8, v8, v9
    v_mov_b32 v9, v8
    s_nop 1
    v_permlane32_swap_b32 v8, v9
    s_nop 0
    v_add_f32 v9, v8, v9
    v_mov_b32 v8, v5
    s_sub_u32 s96, s16, 4
    v_lshlrev_b32 v12, 3, v11
    s_lshl_b32 s18, s96, 5
    s_add_u32 s18, s18, 16384
    v_add_u32 v12, s18, v12
    v_lshlrev_b32 v13, 5, v11
    s_lshl_b32 s18, s96, 11
    v_add_u32 v13, s18, v13
    s_mov_b64 exec, 0xf
    ds_write_b64 v12, v[8:9]
    s_mov_b64 exec, 0xffff
    ds_write_b32 v13, v40 offset:0
    ds_write_b32 v13, v41 offset:512
    ds_write_b32 v13, v42 offset:1024
    ds_write_b32 v13, v43 offset:1536
    ds_write_b32 v13, v44 offset:4
    ds_write_b32 v13, v45 offset:516
    ds_write_b32 v13, v46 offset:1028
    ds_write_b32 v13, v47 offset:1540
    ds_write_b32 v13, v48 offset:8
    ds_write_b32 v13, v49 offset:520
    ds_write_b32 v13, v50 offset:1032
    ds_write_b32 v13, v51 offset:1544
    ds_write_b32 v13, v52 offset:12
    ds_write_b32 v13, v53 offset:524
    ds_write_b32 v13, v54 offset:1036
    ds_write_b32 v13, v55 offset:1548
    ds_write_b32 v13, v56 offset:16
    ds_write_b32 v13, v57 offset:528
    ds_write_b32 v13, v58 offset:1040
    ds_write_b32 v13, v59 offset:1552
    ds_write_b32 v13, v60 offset:20
    ds_write_b32 v13, v61 offset:532
    ds_write_b32 v13, v62 offset:1044
    ds_write_b32 v13, v63 offset:1556
    ds_write_b32 v13, v64 offset:24
    ds_write_b32 v13, v65 offset:536
    ds_write_b32 v13, v66 offset:1048
    ds_write_b32 v13, v67 offset:1560
    ds_write_b32 v13, v68 offset:28
    ds_write_b32 v13, v69 offset:540
    ds_write_b32 v13, v70 offset:1052
    ds_write_b32 v13, v71 offset:1564
    s_mov_b64 exec, -1
    s_waitcnt vmcnt(0) lgkmcnt(0)
    s_barrier
    s_barrier
    s_barrier
    s_branch L_ojoin
L_helper:
    s_mov_b32 s88, s76
    s_and_b32 s89, s77, 0xffff
    s_mov_b32 s90, 4194304
    s_mov_b32 s91, 0x00020000
    s_lshl_b32 s17, s94, 7
    s_lshl_b32 s18, s16, 5
    s_add_u32 s17, s17, s18
    v_lshl_add_u32 v14, v233, 3, s17
    v_lshlrev_b32 v14, 10, v14
    v_lshl_add_u32 v14, v232, 4, v14
    s_lshl_b32 s17, s95, 8
    v_add_u32 v14, s17, v14
    v_add_u32 v15, 0x1000, v14
    buffer_load_dwordx4 v[136:139], v14, s[88:91], 0 offen offset:0
    buffer_load_dwordx4 v[140:143], v14, s[88:91], 0 offen offset:1024
    buffer_load_dwordx4 v[144:147], v14, s[88:91], 0 offen offset:2048
    buffer_load_dwordx4 v[148:151], v14, s[88:91], 0 offen offset:3072
    buffer_load_dwordx4 v[152:155], v15, s[88:91], 0 offen offset:0
    buffer_load_dwordx4 v[156:159], v15, s[88:91], 0 offen offset:1024
    buffer_load_dwordx4 v[160:163], v15, s[88:91], 0 offen offset:2048
    buffer_load_dwordx4 v[164:167], v15, s[88:91], 0 offen offset:3072
    s_mul_i32 s17, s3, 262144
    s_add_u32 s17, s17, 1048576
    s_add_u32 s18, s12, s17
    s_addc_u32 s19, s13, 0
    s_mov_b32 s84, s18
    s_and_b32 s85, s19, 0xffff
    s_mov_b32 s86, 262144
    s_mov_b32 s87, 0x00020000
    s_mul_i32 s17, s3, 4096
    s_add_u32 s17, s17, 2097152
    s_add_u32 s18, s12, s17
    s_addc_u32 s19, s13, 0
    s_mov_b32 s56, s18
    s_and_b32 s57, s19, 0xffff
    s_mov_b32 s58, 4096
    s_mov_b32 s59, 0x00020000
    v_mul_u32_u24 v24, 32768, v232
    s_lshl_b32 s17, s16, 7
    v_add_u32 v24, s17, v24
    v_lshl_add_u32 v24, v233, 5, v24
    v_mul_u32_u24 v25, 512, v232
    s_lshl_b32 s18, s16, 12
    v_lshl_add_u32 v26, v233, 11, s18
    v_lshl_add_u32 v26, v232, 5, v26
    s_lshl_b32 s17, s16, 3
    v_mov_b32 v16, s17
    s_lshl_b32 s17, s16, 9
    v_lshl_add_u32 v17, v11, 3, s17
    s_lshl_b32 s18, s3, 6
    s_add_u32 s18, s18, s14
    s_lshl_b32 s18, s18, 2
    s_add_u32 s18, s18, s16
    s_mul_i32 s19, s18, 1024
    s_lshl_b32 s36, s15, 9
    s_add_u32 s19, s19, s36
    s_add_u32 s19, s19, 1048576
    s_mul_i32 s37, s18, 16
    s_lshl_b32 s36, s15, 3
    s_add_u32 s37, s37, s36
    s_add_u32 s37, s37, 2097152
    v_lshlrev_b32 v23, 3, v11
    s_cmp_lg_u32 s16, 0
    s_cbranch_scc1 L_noz
    s_mov_b32 s17, 48
    s_mov_b32 s38, 400000
L_poll_z:
    buffer_load_dword v9, v234, s[60:63], s17 offen sc1
    s_waitcnt vmcnt(0)
    v_readfirstlane_b32 s39, v9
    s_cmp_ge_u32 s39, 32
    s_cbranch_scc1 L_polld_z
    s_sleep 64
    s_sub_u32 s38, s38, 1
    s_cmp_lg_u32 s38, 0
    s_cbranch_scc1 L_poll_z
L_polld_z:
L_noz:
    s_waitcnt vmcnt(0)
    s_barrier
    ds_read_b64 v[72:73], v16 offset:16384
    ds_read_b64 v[74:75], v16 offset:16416
    ds_read_b64 v[76:77], v16 offset:16448
    ds_read_b64 v[78:79], v16 offset:16480
    ds_read_b64 v[104:105], v17 offset:0
    ds_read_b64 v[106:107], v17 offset:2048
    ds_read_b64 v[108:109], v17 offset:4096
    ds_read_b64 v[110:111], v17 offset:6144
    s_waitcnt lgkmcnt(0)
    v_max_f32 v18, v72, v74
    v_max_f32 v18, v18, v76
    v_max_f32 v18, v18, v78
    v_mov_b32 v19, 0
    v_mov_b32 v20, 0
    v_mov_b32 v21, 0
    v_sub_f32 v22, v72, v18
    v_mul_f32 v22, s42, v22
    v_exp_f32 v22, v22
    s_nop 0
    v_fmac_f32 v19, v22, v73
    v_fmac_f32 v20, v22, v104
    v_fmac_f32 v21, v22, v105
    v_sub_f32 v22, v74, v18
    v_mul_f32 v22, s42, v22
    v_exp_f32 v22, v22
    s_nop 0
    v_fmac_f32 v19, v22, v75
    v_fmac_f32 v20, v22, v106
    v_fmac_f32 v21, v22, v107
    v_sub_f32 v22, v76, v18
    v_mul_f32 v22, s42, v22
    v_exp_f32 v22, v22
    s_nop 0
    v_fmac_f32 v19, v22, v77
    v_fmac_f32 v20, v22, v108
    v_fmac_f32 v21, v22, v109
    v_sub_f32 v22, v78, v18
    v_mul_f32 v22, s42, v22
    v_exp_f32 v22, v22
    s_nop 0
    v_fmac_f32 v19, v22, v79
    v_fmac_f32 v20, v22, v110
    v_fmac_f32 v21, v22, v111
    buffer_store_dwordx2 v[20:21], v23, s[28:31], s19 offen sc1
    s_mov_b64 exec, 1
    buffer_store_dwordx2 v[18:19], v234, s[28:31], s37 offen sc1
    s_mov_b64 exec, -1
    s_waitcnt vmcnt(0)
    s_barrier
    s_cmp_lg_u32 s16, 0
    s_cbranch_scc1 L_pub_np
    s_mov_b64 exec, 1
    s_add_u32 s17, s82, 0
    v_mov_b32 v8, 1
    buffer_atomic_add v8, v234, s[60:63], s17 offen sc0
    s_waitcnt vmcnt(0)
    s_mov_b64 exec, -1
    v_readfirstlane_b32 s39, v8
    s_and_b32 s39, s39, 15
    s_cmp_lg_u32 s39, 15
    s_cbranch_scc1 L_waitflag
    v_lshrrev_b32 v8, 1, v11
    v_lshlrev_b32 v8, 4, v8
    v_and_b32 v9, 1, v11
    v_add_u32 v8, v8, v9
    v_lshlrev_b32 v8, 7, v8
    s_lshl_b32 s17, s3, 7
    s_lshl_b32 s18, s78, 1
    s_add_u32 s17, s17, s18
    s_lshl_b32 s17, s17, 7
    s_add_u32 s17, s17, 2195456
    s_mov_b64 exec, 0xffff
    buffer_store_dword v237, v8, s[28:31], s17 offen sc1
    s_mov_b64 exec, -1
    s_branch L_flagdone
L_waitflag:
    s_mov_b32 s38, 400000
L_poll_o:
    buffer_load_dword v9, v234, s[28:31], s46 offen sc1
    s_waitcnt vmcnt(0)
    v_readfirstlane_b32 s39, v9
    s_cmp_ge_u32 s39, 1
    s_cbranch_scc1 L_polld_o
    s_sleep 4
    s_sub_u32 s38, s38, 1
    s_cmp_lg_u32 s38, 0
    s_cbranch_scc1 L_poll_o
L_polld_o:
L_flagdone:
L_pub_np:
    s_barrier
    s_mul_i32 s17, s94, 1024
    buffer_load_dwordx4 v[104:107], v24, s[84:87], s17 offen offset:0 sc1
    buffer_load_dwordx4 v[108:111], v24, s[84:87], s17 offen offset:16 sc1
    buffer_load_dwordx4 v[112:115], v24, s[84:87], s17 offen offset:512 sc1
    buffer_load_dwordx4 v[116:119], v24, s[84:87], s17 offen offset:528 sc1
    s_mul_i32 s17, s94, 16
    buffer_load_dwordx4 v[120:123], v25, s[56:59], s17 offen sc1
    s_waitcnt vmcnt(0)
    v_max_f32 v19, v120, v122
    v_sub_f32 v120, v120, v19
    v_mul_f32 v120, s42, v120
    v_exp_f32 v120, v120
    v_sub_f32 v122, v122, v19
    v_mul_f32 v122, s42, v122
    v_exp_f32 v122, v122
    s_nop 0
    v_mul_f32 v19, v120, v121
    v_fmac_f32 v19, v122, v123
    v_rcp_f32 v19, v19
    s_nop 0
    v_mul_f32 v120, v120, v19
    v_mul_f32 v122, v122, v19
    v_mul_f32 v104, v104, v120
    v_fmac_f32 v104, v112, v122
    v_mul_f32 v105, v105, v120
    v_fmac_f32 v105, v113, v122
    v_mul_f32 v106, v106, v120
    v_fmac_f32 v106, v114, v122
    v_mul_f32 v107, v107, v120
    v_fmac_f32 v107, v115, v122
    v_mul_f32 v108, v108, v120
    v_fmac_f32 v108, v116, v122
    v_mul_f32 v109, v109, v120
    v_fmac_f32 v109, v117, v122
    v_mul_f32 v110, v110, v120
    v_fmac_f32 v110, v118, v122
    v_mul_f32 v111, v111, v120
    v_fmac_f32 v111, v119, v122
    v_cvt_pk_bf16_f32 v36, v104, v105
    v_cvt_pk_bf16_f32 v37, v106, v107
    v_cvt_pk_bf16_f32 v38, v108, v109
    v_cvt_pk_bf16_f32 v39, v110, v111
    v_perm_b32 v200, v140, v136, s40
    v_perm_b32 v201, v148, v144, s40
    v_perm_b32 v202, v156, v152, s40
    v_perm_b32 v203, v164, v160, s40
    v_perm_b32 v204, v140, v136, s41
    v_perm_b32 v205, v148, v144, s41
    v_perm_b32 v206, v156, v152, s41
    v_perm_b32 v207, v164, v160, s41
    v_mfma_f32_16x16x32_bf16 v[40:43], v[36:39], v[200:203], 0
    v_perm_b32 v208, v141, v137, s40
    v_perm_b32 v209, v149, v145, s40
    v_perm_b32 v210, v157, v153, s40
    v_perm_b32 v211, v165, v161, s40
    v_mfma_f32_16x16x32_bf16 v[44:47], v[36:39], v[204:207], 0
    v_perm_b32 v212, v141, v137, s41
    v_perm_b32 v213, v149, v145, s41
    v_perm_b32 v214, v157, v153, s41
    v_perm_b32 v215, v165, v161, s41
    v_mfma_f32_16x16x32_bf16 v[48:51], v[36:39], v[208:211], 0
    v_perm_b32 v216, v142, v138, s40
    v_perm_b32 v217, v150, v146, s40
    v_perm_b32 v218, v158, v154, s40
    v_perm_b32 v219, v166, v162, s40
    v_mfma_f32_16x16x32_bf16 v[52:55], v[36:39], v[212:215], 0
    v_perm_b32 v220, v142, v138, s41
    v_perm_b32 v221, v150, v146, s41
    v_perm_b32 v222, v158, v154, s41
    v_perm_b32 v223, v166, v162, s41
    v_mfma_f32_16x16x32_bf16 v[56:59], v[36:39], v[216:219], 0
    v_perm_b32 v224, v143, v139, s40
    v_perm_b32 v225, v151, v147, s40
    v_perm_b32 v226, v159, v155, s40
    v_perm_b32 v227, v167, v163, s40
    v_mfma_f32_16x16x32_bf16 v[60:63], v[36:39], v[220:223], 0
    v_perm_b32 v228, v143, v139, s41
    v_perm_b32 v229, v151, v147, s41
    v_perm_b32 v230, v159, v155, s41
    v_perm_b32 v231, v167, v163, s41
    v_mfma_f32_16x16x32_bf16 v[64:67], v[36:39], v[224:227], 0
    s_nop 1
    v_mfma_f32_16x16x32_bf16 v[68:71], v[36:39], v[228:231], 0
    s_nop 7
    s_mov_b32 exec_lo, -1
    s_mov_b32 exec_hi, 0
    ds_write_b32 v26, v40 offset:0
    ds_write_b32 v26, v41 offset:512
    ds_write_b32 v26, v42 offset:1024
    ds_write_b32 v26, v43 offset:1536
    ds_write_b32 v26, v44 offset:4
    ds_write_b32 v26, v45 offset:516
    ds_write_b32 v26, v46 offset:1028
    ds_write_b32 v26, v47 offset:1540
    ds_write_b32 v26, v48 offset:8
    ds_write_b32 v26, v49 offset:520
    ds_write_b32 v26, v50 offset:1032
    ds_write_b32 v26, v51 offset:1544
    ds_write_b32 v26, v52 offset:12
    ds_write_b32 v26, v53 offset:524
    ds_write_b32 v26, v54 offset:1036
    ds_write_b32 v26, v55 offset:1548
    ds_write_b32 v26, v56 offset:16
    ds_write_b32 v26, v57 offset:528
    ds_write_b32 v26, v58 offset:1040
    ds_write_b32 v26, v59 offset:1552
    ds_write_b32 v26, v60 offset:20
    ds_write_b32 v26, v61 offset:532
    ds_write_b32 v26, v62 offset:1044
    ds_write_b32 v26, v63 offset:1556
    ds_write_b32 v26, v64 offset:24
    ds_write_b32 v26, v65 offset:536
    ds_write_b32 v26, v66 offset:1048
    ds_write_b32 v26, v67 offset:1560
    ds_write_b32 v26, v68 offset:28
    ds_write_b32 v26, v69 offset:540
    ds_write_b32 v26, v70 offset:1052
    ds_write_b32 v26, v71 offset:1564
    s_mov_b64 exec, -1
    s_waitcnt lgkmcnt(0)
L_ojoin:
    s_barrier
    v_lshlrev_b32 v8, 2, v0
    ds_read_b32 v72, v8 offset:0
    ds_read_b32 v73, v8 offset:4096
    ds_read_b32 v74, v8 offset:8192
    ds_read_b32 v75, v8 offset:12288
    ds_read_b32 v76, v8 offset:2048
    ds_read_b32 v77, v8 offset:6144
    ds_read_b32 v78, v8 offset:10240
    ds_read_b32 v79, v8 offset:14336
    v_lshrrev_b32 v9, 7, v0
    v_and_b32 v10, 127, v0
    v_lshlrev_b32 v9, 12, v9
    v_lshl_add_u32 v9, v10, 2, v9
    s_lshl_b32 s17, s3, 11
    s_lshl_b32 s18, s95, 9
    s_add_u32 s17, s17, s18
    s_add_u32 s17, s17, 2162688
    s_add_u32 s18, s17, 16384
    s_waitcnt lgkmcnt(0)
    v_add_f32 v72, v72, v73
    v_add_f32 v74, v74, v75
    v_add_f32 v76, v76, v77
    v_add_f32 v78, v78, v79
    v_add_f32 v72, v72, v74
    v_add_f32 v76, v76, v78
    buffer_atomic_add_f32 v72, v9, s[28:31], s17 offen
    buffer_atomic_add_f32 v76, v9, s[28:31], s18 offen
    s_waitcnt vmcnt(0)
    s_barrier
    s_cmp_lg_u32 s16, 0
    s_cbranch_scc1 L_fin
    s_lshl_b32 s19, s95, 6
    s_lshl_b32 s18, s3, 2
    s_add_u32 s19, s19, s18
    s_add_u32 s19, s19, 32
    v_mov_b32 v8, 1
    s_mov_b64 exec, 1
    buffer_atomic_add v8, v234, s[60:63], s19 offen sc0
    s_waitcnt vmcnt(0)
    s_mov_b64 exec, -1
    v_readfirstlane_b32 s19, v8
    s_and_b32 s19, s19, 31
    s_cmp_lg_u32 s19, 31
    s_cbranch_scc1 L_fin
    v_lshlrev_b32 v9, 3, v11
    v_mov_b32 v72, 0
    v_mov_b32 v73, 0
    v_mov_b32 v74, 0
    v_mov_b32 v75, 0
    v_mov_b32 v76, 0
    v_mov_b32 v77, 0
    v_mov_b32 v78, 0
    v_mov_b32 v79, 0
    v_mov_b32 v80, 0
    v_mov_b32 v81, 0
    v_mov_b32 v82, 0
    v_mov_b32 v83, 0
    v_mov_b32 v84, 0
    v_mov_b32 v85, 0
    v_mov_b32 v86, 0
    v_mov_b32 v87, 0
    s_mov_b32 s18, s17
    buffer_atomic_add_f32 v72, v9, s[28:31], s18 offen sc0
    buffer_atomic_add_f32 v73, v9, s[28:31], s18 offen offset:4 sc0
    s_add_u32 s18, s18, 4096
    buffer_atomic_add_f32 v74, v9, s[28:31], s18 offen sc0
    buffer_atomic_add_f32 v75, v9, s[28:31], s18 offen offset:4 sc0
    s_add_u32 s18, s18, 4096
    buffer_atomic_add_f32 v76, v9, s[28:31], s18 offen sc0
    buffer_atomic_add_f32 v77, v9, s[28:31], s18 offen offset:4 sc0
    s_add_u32 s18, s18, 4096
    buffer_atomic_add_f32 v78, v9, s[28:31], s18 offen sc0
    buffer_atomic_add_f32 v79, v9, s[28:31], s18 offen offset:4 sc0
    s_add_u32 s18, s18, 4096
    buffer_atomic_add_f32 v80, v9, s[28:31], s18 offen sc0
    buffer_atomic_add_f32 v81, v9, s[28:31], s18 offen offset:4 sc0
    s_add_u32 s18, s18, 4096
    buffer_atomic_add_f32 v82, v9, s[28:31], s18 offen sc0
    buffer_atomic_add_f32 v83, v9, s[28:31], s18 offen offset:4 sc0
    s_add_u32 s18, s18, 4096
    buffer_atomic_add_f32 v84, v9, s[28:31], s18 offen sc0
    buffer_atomic_add_f32 v85, v9, s[28:31], s18 offen offset:4 sc0
    s_add_u32 s18, s18, 4096
    buffer_atomic_add_f32 v86, v9, s[28:31], s18 offen sc0
    buffer_atomic_add_f32 v87, v9, s[28:31], s18 offen offset:4 sc0
    s_mov_b32 s64, s52
    s_and_b32 s65, s53, 0xffff
    s_mov_b32 s66, 16384
    s_mov_b32 s67, 0x00020000
    s_lshl_b32 s18, s3, 10
    s_lshl_b32 s19, s95, 8
    s_add_u32 s18, s18, s19
    v_lshlrev_b32 v10, 2, v11
    s_waitcnt vmcnt(0)
    v_cvt_pk_bf16_f32 v72, v72, v73
    buffer_store_dword v72, v10, s[64:67], s18 offen
    s_add_u32 s18, s18, 2048
    v_cvt_pk_bf16_f32 v74, v74, v75
    buffer_store_dword v74, v10, s[64:67], s18 offen
    s_add_u32 s18, s18, 2048
    v_cvt_pk_bf16_f32 v76, v76, v77
    buffer_store_dword v76, v10, s[64:67], s18 offen
    s_add_u32 s18, s18, 2048
    v_cvt_pk_bf16_f32 v78, v78, v79
    buffer_store_dword v78, v10, s[64:67], s18 offen
    s_add_u32 s18, s18, 2048
    v_cvt_pk_bf16_f32 v80, v80, v81
    buffer_store_dword v80, v10, s[64:67], s18 offen
    s_add_u32 s18, s18, 2048
    v_cvt_pk_bf16_f32 v82, v82, v83
    buffer_store_dword v82, v10, s[64:67], s18 offen
    s_add_u32 s18, s18, 2048
    v_cvt_pk_bf16_f32 v84, v84, v85
    buffer_store_dword v84, v10, s[64:67], s18 offen
    s_add_u32 s18, s18, 2048
    v_cvt_pk_bf16_f32 v86, v86, v87
    buffer_store_dword v86, v10, s[64:67], s18 offen
L_fin:
L_end:
    s_endpgm
.section .rodata,"a"
.p2align 6
.amdhsa_kernel concat_heads__gqa_block_cached__gqa_block_cached__decode_kernel
  .amdhsa_next_free_vgpr 238
  .amdhsa_next_free_sgpr 102
  .amdhsa_accum_offset 240
  .amdhsa_group_segment_fixed_size 0
  .amdhsa_kernarg_size 104
  .amdhsa_user_sgpr_count 2
  .amdhsa_user_sgpr_kernarg_segment_ptr 1
  .amdhsa_system_sgpr_workgroup_id_x 1
  .amdhsa_float_denorm_mode_32 3
.end_amdhsa_kernel
```
